```python
import torch

def _softmax(x, axis=-1):
    return torch.softmax(x, dim=axis)
def _gelu(x):
    return torch.nn.functional.gelu(x, approximate="tanh")
def _silu(x):
    return torch.nn.functional.silu(x)
def _sigmoid(x):
    return torch.sigmoid(x)
def _layernorm(x, axis=-1, eps=1e-5):
    m = x.mean(dim=axis, keepdim=True)
    v = x.var(dim=axis, keepdim=True, unbiased=False)
    return (x - m) / torch.sqrt(v + eps)
def _scatter_add(tgt, idx, src, axis=0):
    return tgt.clone().index_add_(axis, idx, src)
def _segment_sum(src, seg, n):
    out = torch.zeros((n,) + src.shape[1:], dtype=src.dtype)
    return out.index_add_(0, seg, src)
def _pad(x, pw):
    flat = tuple(v for pair in reversed(pw) for v in pair)
    return torch.nn.functional.pad(x, flat)

kernel_name = 'standalone__sliding_local_fixed_window__prompt'

def setup_inputs():

    _w = (lambda a: (lambda t: t.to(torch.bfloat16) if t.is_floating_point() else t)(torch.as_tensor(a)))
    B, H, S, D = 1, 32, 2048, 128
    return {
        "q": _w((lambda *s: torch.randn(*s, dtype=torch.bfloat16) * 0.8)(B, H, S, D)),
        "k": _w((lambda *s: torch.randn(*s, dtype=torch.bfloat16) * 0.8)(B, H, S, D)),
        "v": _w((lambda *s: torch.randn(*s, dtype=torch.bfloat16) * 0.05)(B, H, S, D)),
    }

def reference(q, k, v):
    B, H, S, D = q.shape
    w = 32
    pos = torch.arange(S)
    rel = pos[:, None] - pos[None, :]
    mask = (rel >= 0) & (rel < w)
    scores = torch.einsum("bhqd,bhkd->bhqk", q, k) * (D ** -0.5)
    scores = torch.where(mask[None, None], scores, (lambda x, dt: x.to(dt))(torch.as_tensor(-1e9), q.dtype))
    p = _softmax(scores, axis=-1)
    return torch.einsum("bhqk,bhkd->bhqd", p, v)
```

```asm
; @launch grid=(256,1,1) block=(384,1,1) lds=160512
.amdgcn_target "amdgcn-amd-amdhsa--gfx950"
.text
.globl standalone__sliding_local_fixed_window__prompt_kernel
.p2align 8
.type standalone__sliding_local_fixed_window__prompt_kernel,@function
standalone__sliding_local_fixed_window__prompt_kernel:
    s_load_dwordx2 s[20:21], s[0:1], 8
    s_load_dwordx2 s[16:17], s[0:1], 0
    s_load_dwordx2 s[24:25], s[0:1], 16
    s_load_dwordx2 s[28:29], s[0:1], 24
    s_and_b32 s47, s2, 0x18
    s_load_dwordx2 s[8:9], s[0:1], s47
    v_readfirstlane_b32 s3, v0
    s_cmp_ge_u32 s2, 256
    s_cbranch_scc1 L_end
    s_getpc_b64 s[44:45]
    v_mul_u32_u24 v2, 20, v0
    global_load_dword v11, v2, s[44:45] offset:448
    v_and_b32 v1, 63, v0
    v_lshlrev_b32 v3, 2, v1
    v_add_u32 v3, 159744, v3
    v_mov_b32 v4, 0
    s_bfe_u32 s13, s2, 0x30003
    s_lshr_b32 s12, s2, 6
    s_lshl4_add_u32 s13, s12, s13
    s_and_b32 s12, s2, 1
    s_lshl3_add_u32 s13, s12, s13
    s_and_b32 s12, s2, 6
    s_lshl_b32 s12, s12, 5
    s_add_u32 s2, s12, s13
    s_lshl_b32 s12, s2, 16
    s_mov_b32 s18, 0x1000000
    s_mov_b32 s19, 0x20000
    s_mov_b64 s[22:23], s[18:19]
    s_mov_b64 s[26:27], s[18:19]
    s_mov_b64 s[30:31], s[18:19]
    s_mov_b64 s[10:11], s[18:19]
    v_lshrrev_b32 v5, 4, v1
    v_lshlrev_b32 v10, 4, v1
    s_cmp_lg_u32 s3, 0
    s_cbranch_scc0 L_loader
    s_barrier
    s_branch L_cons
L_loader:
    ds_write2st64_b32 v3, v4, v4 offset1:1
    ds_write_b32 v3, v4 offset:512
    v_xor_b32 v6, v1, v5
    v_lshlrev_b32 v6, 4, v6
    v_xor_b32 v7, 64, v6
    v_xor_b32 v8, 0x80, v6
    v_xor_b32 v9, 64, v8
    s_add_u32 s15, s12, 61440
    s_movk_i32 m0, 4096
    s_setprio 3
    s_waitcnt lgkmcnt(0)
    s_buffer_load_dword s6, s[8:11], s12
    buffer_load_dwordx4 v6, s[20:23], s15 offen offset:0 lds
    buffer_load_dwordx4 v7, s[20:23], s15 offen offset:1024 lds
    buffer_load_dwordx4 v8, s[20:23], s15 offen offset:2048 lds
    buffer_load_dwordx4 v9, s[20:23], s15 offen offset:3072 lds
    s_addk_i32 m0, 12288
    s_addk_i32 s15, -4096
    buffer_load_dwordx4 v6, s[20:23], s15 offen offset:0 lds
    buffer_load_dwordx4 v7, s[20:23], s15 offen offset:1024 lds
    buffer_load_dwordx4 v8, s[20:23], s15 offen offset:2048 lds
    buffer_load_dwordx4 v9, s[20:23], s15 offen offset:3072 lds
    s_addk_i32 m0, 12288
    s_addk_i32 s15, -4096
    buffer_load_dwordx4 v6, s[20:23], s15 offen offset:0 nt lds
    buffer_load_dwordx4 v7, s[20:23], s15 offen offset:1024 nt lds
    buffer_load_dwordx4 v8, s[20:23], s15 offen offset:2048 nt lds
    buffer_load_dwordx4 v9, s[20:23], s15 offen offset:3072 nt lds
    s_addk_i32 m0, -28672
    s_addk_i32 s15, 8192
    buffer_load_dwordx4 v6, s[16:19], s15 offen offset:0 nt lds
    buffer_load_dwordx4 v7, s[16:19], s15 offen offset:1024 nt lds
    buffer_load_dwordx4 v8, s[16:19], s15 offen offset:2048 nt lds
    buffer_load_dwordx4 v9, s[16:19], s15 offen offset:3072 nt lds
    s_addk_i32 m0, 8192
    s_nop 0
    buffer_load_dwordx4 v10, s[24:27], s15 offen offset:0 lds
    buffer_load_dwordx4 v10, s[24:27], s15 offen offset:1024 lds
    buffer_load_dwordx4 v10, s[24:27], s15 offen offset:2048 lds
    buffer_load_dwordx4 v10, s[24:27], s15 offen offset:3072 lds
    s_addk_i32 m0, 12288
    s_addk_i32 s15, -4096
    s_barrier
L_burst_end:
    s_sub_u32 s47, s12, 8192
    s_and_b32 s46, s2, 7
    s_cselect_b32 s47, s47, 0
    s_cselect_b32 s46, s18, 0
    s_waitcnt vmcnt(19)
    buffer_load_dwordx4 v10, s[24:27], s15 offen offset:0 lds
    s_waitcnt vmcnt(19)
    buffer_load_dwordx4 v10, s[24:27], s15 offen offset:1024 lds
    s_waitcnt vmcnt(19)
    buffer_load_dwordx4 v10, s[24:27], s15 offen offset:2048 lds
    v_mov_b32 v4, 1
    s_waitcnt vmcnt(19)
    ds_write_b32 v3, v4
    buffer_load_dwordx4 v10, s[24:27], s15 offen offset:3072 lds
    s_addk_i32 m0, 12288
    s_addk_i32 s15, -4096
    s_waitcnt vmcnt(19)
    buffer_load_dwordx4 v10, s[24:27], s15 offen offset:0 nt lds
    s_waitcnt vmcnt(19)
    buffer_load_dwordx4 v10, s[24:27], s15 offen offset:1024 nt lds
    s_waitcnt vmcnt(19)
    buffer_load_dwordx4 v10, s[24:27], s15 offen offset:2048 nt lds
    v_mov_b32 v4, 2
    s_waitcnt vmcnt(19)
    ds_write_b32 v3, v4
    buffer_load_dwordx4 v10, s[24:27], s15 offen offset:3072 nt lds
    s_addk_i32 m0, 8192
    s_addk_i32 s15, -4096
    s_waitcnt vmcnt(19)
    buffer_load_dwordx4 v6, s[20:23], s15 offen offset:0 nt lds
    s_waitcnt vmcnt(19)
    buffer_load_dwordx4 v7, s[20:23], s15 offen offset:1024 nt lds
    s_waitcnt vmcnt(19)
    buffer_load_dwordx4 v8, s[20:23], s15 offen offset:2048 nt lds
    v_mov_b32 v4, 3
    s_waitcnt vmcnt(19)
    ds_write_b32 v3, v4
    buffer_load_dwordx4 v9, s[20:23], s15 offen offset:3072 nt lds
    s_addk_i32 m0, -28672
    s_addk_i32 s15, 8192
    s_waitcnt vmcnt(19)
    buffer_load_dwordx4 v6, s[16:19], s15 offen offset:0 nt lds
    s_waitcnt vmcnt(19)
    buffer_load_dwordx4 v7, s[16:19], s15 offen offset:1024 nt lds
    s_waitcnt vmcnt(19)
    buffer_load_dwordx4 v8, s[16:19], s15 offen offset:2048 nt lds
    v_mov_b32 v4, 4
    s_waitcnt vmcnt(19)
    ds_write_b32 v3, v4
    buffer_load_dwordx4 v9, s[16:19], s15 offen offset:3072 nt lds
    s_mov_b32 m0, 45056
    s_addk_i32 s15, -8192
    s_waitcnt vmcnt(19)
    buffer_load_dwordx4 v10, s[24:27], s15 offen offset:0 nt lds
    s_waitcnt vmcnt(19)
    buffer_load_dwordx4 v10, s[24:27], s15 offen offset:1024 nt lds
    s_waitcnt vmcnt(19)
    buffer_load_dwordx4 v10, s[24:27], s15 offen offset:2048 nt lds
    v_mov_b32 v4, 5
    s_waitcnt vmcnt(19)
    ds_write_b32 v3, v4
    buffer_load_dwordx4 v10, s[24:27], s15 offen offset:3072 nt lds
    s_addk_i32 m0, 8192
    s_addk_i32 s15, -4096
    s_waitcnt vmcnt(19)
    buffer_load_dwordx4 v6, s[20:23], s15 offen offset:0 nt lds
    s_waitcnt vmcnt(19)
    buffer_load_dwordx4 v7, s[20:23], s15 offen offset:1024 nt lds
    s_waitcnt vmcnt(19)
    buffer_load_dwordx4 v8, s[20:23], s15 offen offset:2048 nt lds
    v_mov_b32 v4, 6
    s_waitcnt vmcnt(19)
    ds_write_b32 v3, v4
    buffer_load_dwordx4 v9, s[20:23], s15 offen offset:3072 nt lds
    s_addk_i32 m0, -28672
    s_addk_i32 s15, 8192
    s_waitcnt vmcnt(19)
    buffer_load_dwordx4 v6, s[16:19], s15 offen offset:0 nt lds
    s_waitcnt vmcnt(19)
    buffer_load_dwordx4 v7, s[16:19], s15 offen offset:1024 nt lds
    s_waitcnt vmcnt(19)
    buffer_load_dwordx4 v8, s[16:19], s15 offen offset:2048 nt lds
    v_mov_b32 v4, 7
    s_waitcnt vmcnt(19)
    ds_write_b32 v3, v4
    buffer_load_dwordx4 v9, s[16:19], s15 offen offset:3072 nt lds
    s_mov_b32 m0, 57344
    s_addk_i32 s15, -8192
    s_waitcnt vmcnt(19)
    buffer_load_dwordx4 v10, s[24:27], s15 offen offset:0 nt lds
    s_waitcnt vmcnt(19)
    buffer_load_dwordx4 v10, s[24:27], s15 offen offset:1024 nt lds
    s_waitcnt vmcnt(19)
    buffer_load_dwordx4 v10, s[24:27], s15 offen offset:2048 nt lds
    v_mov_b32 v4, 8
    s_waitcnt vmcnt(19)
    ds_write_b32 v3, v4
    buffer_load_dwordx4 v10, s[24:27], s15 offen offset:3072 nt lds
    s_addk_i32 m0, 8192
    s_addk_i32 s15, -4096
    s_waitcnt vmcnt(19)
    buffer_load_dwordx4 v6, s[20:23], s15 offen offset:0 nt lds
    s_waitcnt vmcnt(19)
    buffer_load_dwordx4 v7, s[20:23], s15 offen offset:1024 nt lds
    s_waitcnt vmcnt(19)
    buffer_load_dwordx4 v8, s[20:23], s15 offen offset:2048 nt lds
    v_mov_b32 v4, 9
    s_waitcnt vmcnt(19)
    ds_write_b32 v3, v4
    buffer_load_dwordx4 v9, s[20:23], s15 offen offset:3072 nt lds
    s_addk_i32 m0, -28672
    s_addk_i32 s15, 8192
    s_waitcnt vmcnt(19)
    buffer_load_dwordx4 v6, s[16:19], s15 offen offset:0 nt lds
    s_waitcnt vmcnt(19)
    buffer_load_dwordx4 v7, s[16:19], s15 offen offset:1024 nt lds
    s_waitcnt vmcnt(19)
    buffer_load_dwordx4 v8, s[16:19], s15 offen offset:2048 nt lds
    v_mov_b32 v4, 10
    s_waitcnt vmcnt(19)
    ds_write_b32 v3, v4
    buffer_load_dwordx4 v9, s[16:19], s15 offen offset:3072 nt lds
    s_mov_b32 m0, 69632
    s_addk_i32 s15, -8192
    s_waitcnt vmcnt(19)
    buffer_load_dwordx4 v10, s[24:27], s15 offen offset:0 nt lds
    s_waitcnt vmcnt(19)
    buffer_load_dwordx4 v10, s[24:27], s15 offen offset:1024 nt lds
    s_waitcnt vmcnt(19)
    buffer_load_dwordx4 v10, s[24:27], s15 offen offset:2048 nt lds
    v_mov_b32 v4, 11
    s_waitcnt vmcnt(19)
    ds_write_b32 v3, v4
    buffer_load_dwordx4 v10, s[24:27], s15 offen offset:3072 nt lds
    s_addk_i32 m0, 8192
    s_addk_i32 s15, -4096
    s_waitcnt vmcnt(19)
    buffer_load_dwordx4 v6, s[20:23], s15 offen offset:0 nt lds
    s_waitcnt vmcnt(19)
    buffer_load_dwordx4 v7, s[20:23], s15 offen offset:1024 nt lds
    s_waitcnt vmcnt(19)
    buffer_load_dwordx4 v8, s[20:23], s15 offen offset:2048 nt lds
    v_mov_b32 v4, 12
    s_waitcnt vmcnt(19)
    ds_write_b32 v3, v4
    buffer_load_dwordx4 v9, s[20:23], s15 offen offset:3072 nt lds
    s_addk_i32 m0, -28672
    s_addk_i32 s15, 8192
    s_waitcnt vmcnt(19)
    buffer_load_dwordx4 v6, s[16:19], s15 offen offset:0 nt lds
    s_waitcnt vmcnt(19)
    buffer_load_dwordx4 v7, s[16:19], s15 offen offset:1024 nt lds
    s_waitcnt vmcnt(19)
    buffer_load_dwordx4 v8, s[16:19], s15 offen offset:2048 nt lds
    v_mov_b32 v4, 13
    s_waitcnt vmcnt(19)
    ds_write_b32 v3, v4
    buffer_load_dwordx4 v9, s[16:19], s15 offen offset:3072 nt lds
    s_mov_b32 m0, 81920
    s_addk_i32 s15, -8192
    s_waitcnt vmcnt(19)
    buffer_load_dwordx4 v10, s[24:27], s15 offen offset:0 nt lds
    s_waitcnt vmcnt(19)
    buffer_load_dwordx4 v10, s[24:27], s15 offen offset:1024 nt lds
    s_waitcnt vmcnt(19)
    buffer_load_dwordx4 v10, s[24:27], s15 offen offset:2048 nt lds
    v_mov_b32 v4, 14
    s_waitcnt vmcnt(19)
    ds_write_b32 v3, v4
    buffer_load_dwordx4 v10, s[24:27], s15 offen offset:3072 nt lds
    s_addk_i32 m0, 8192
    s_addk_i32 s15, -4096
    s_waitcnt vmcnt(19)
    buffer_load_dwordx4 v6, s[20:23], s15 offen offset:0 nt lds
    s_waitcnt vmcnt(19)
    buffer_load_dwordx4 v7, s[20:23], s15 offen offset:1024 nt lds
    s_waitcnt vmcnt(19)
    buffer_load_dwordx4 v8, s[20:23], s15 offen offset:2048 nt lds
    v_mov_b32 v4, 15
    s_waitcnt vmcnt(19)
    ds_write_b32 v3, v4
    buffer_load_dwordx4 v9, s[20:23], s15 offen offset:3072 nt lds
    s_addk_i32 m0, -28672
    s_addk_i32 s15, 8192
    s_waitcnt vmcnt(19)
    buffer_load_dwordx4 v6, s[16:19], s15 offen offset:0 nt lds
    s_waitcnt vmcnt(19)
    buffer_load_dwordx4 v7, s[16:19], s15 offen offset:1024 nt lds
    s_waitcnt vmcnt(19)
    buffer_load_dwordx4 v8, s[16:19], s15 offen offset:2048 nt lds
    v_mov_b32 v4, 16
    s_waitcnt vmcnt(19)
    ds_write_b32 v3, v4
    buffer_load_dwordx4 v9, s[16:19], s15 offen offset:3072 nt lds
    s_mov_b32 m0, 94208
    s_addk_i32 s15, -8192
    s_waitcnt vmcnt(18)
    buffer_load_dwordx4 v10, s[24:27], s15 offen offset:0 nt lds
    s_waitcnt vmcnt(18)
    buffer_load_dwordx4 v10, s[24:27], s15 offen offset:1024 nt lds
    v_mov_b32 v4, 17
    s_waitcnt vmcnt(18)
    ds_write_b32 v3, v4
    buffer_load_dwordx4 v10, s[24:27], s15 offen offset:2048 nt lds
    s_waitcnt vmcnt(18)
    buffer_load_dwordx4 v10, s[24:27], s15 offen offset:3072 nt lds
    s_addk_i32 m0, 8192
    s_addk_i32 s15, -4096
    s_waitcnt vmcnt(18)
    buffer_load_dwordx4 v6, s[20:23], s15 offen offset:0 nt lds
    s_waitcnt vmcnt(18)
    buffer_load_dwordx4 v7, s[20:23], s15 offen offset:1024 nt lds
    v_mov_b32 v4, 18
    s_waitcnt vmcnt(18)
    ds_write_b32 v3, v4
    buffer_load_dwordx4 v8, s[20:23], s15 offen offset:2048 nt lds
    s_waitcnt vmcnt(18)
    buffer_load_dwordx4 v9, s[20:23], s15 offen offset:3072 nt lds
    s_addk_i32 m0, -28672
    s_addk_i32 s15, 8192
    s_waitcnt vmcnt(18)
    buffer_load_dwordx4 v6, s[16:19], s15 offen offset:0 nt lds
    s_waitcnt vmcnt(18)
    buffer_load_dwordx4 v7, s[16:19], s15 offen offset:1024 nt lds
    v_mov_b32 v4, 19
    s_waitcnt vmcnt(18)
    ds_write_b32 v3, v4
    buffer_load_dwordx4 v8, s[16:19], s15 offen offset:2048 nt lds
    s_waitcnt vmcnt(18)
    buffer_load_dwordx4 v9, s[16:19], s15 offen offset:3072 nt lds
    s_mov_b32 m0, 106496
    s_addk_i32 s15, -8192
    s_waitcnt vmcnt(18)
    buffer_load_dwordx4 v10, s[24:27], s15 offen offset:0 nt lds
    s_waitcnt vmcnt(18)
    buffer_load_dwordx4 v10, s[24:27], s15 offen offset:1024 nt lds
    v_mov_b32 v4, 20
    s_waitcnt vmcnt(18)
    ds_write_b32 v3, v4
    buffer_load_dwordx4 v10, s[24:27], s15 offen offset:2048 nt lds
    s_waitcnt vmcnt(18)
    buffer_load_dwordx4 v10, s[24:27], s15 offen offset:3072 nt lds
    s_addk_i32 m0, 8192
    s_addk_i32 s15, -4096
    s_waitcnt vmcnt(18)
    buffer_load_dwordx4 v6, s[20:23], s15 offen offset:0 nt lds
    s_waitcnt vmcnt(18)
    buffer_load_dwordx4 v7, s[20:23], s15 offen offset:1024 nt lds
    v_mov_b32 v4, 21
    s_waitcnt vmcnt(18)
    ds_write_b32 v3, v4
    buffer_load_dwordx4 v8, s[20:23], s15 offen offset:2048 nt lds
    s_waitcnt vmcnt(18)
    buffer_load_dwordx4 v9, s[20:23], s15 offen offset:3072 nt lds
    s_addk_i32 m0, -28672
    s_addk_i32 s15, 8192
    s_waitcnt vmcnt(18)
    buffer_load_dwordx4 v6, s[16:19], s15 offen offset:0 nt lds
    s_waitcnt vmcnt(18)
    buffer_load_dwordx4 v7, s[16:19], s15 offen offset:1024 nt lds
    v_mov_b32 v4, 22
    s_waitcnt vmcnt(18)
    ds_write_b32 v3, v4
    buffer_load_dwordx4 v8, s[16:19], s15 offen offset:2048 nt lds
    s_waitcnt vmcnt(18)
    buffer_load_dwordx4 v9, s[16:19], s15 offen offset:3072 nt lds
    s_mov_b32 m0, 118784
    s_addk_i32 s15, -8192
    s_waitcnt vmcnt(18)
    buffer_load_dwordx4 v10, s[24:27], s15 offen offset:0 nt lds
    s_waitcnt vmcnt(18)
    buffer_load_dwordx4 v10, s[24:27], s15 offen offset:1024 nt lds
    v_mov_b32 v4, 23
    s_waitcnt vmcnt(18)
    ds_write_b32 v3, v4
    buffer_load_dwordx4 v10, s[24:27], s15 offen offset:2048 nt lds
    s_waitcnt vmcnt(18)
    buffer_load_dwordx4 v10, s[24:27], s15 offen offset:3072 nt lds
    s_addk_i32 m0, 8192
    s_addk_i32 s15, -4096
    s_waitcnt vmcnt(18)
    buffer_load_dwordx4 v6, s[20:23], s15 offen offset:0 nt lds
    s_waitcnt vmcnt(18)
    buffer_load_dwordx4 v7, s[20:23], s15 offen offset:1024 nt lds
    v_mov_b32 v4, 24
    s_waitcnt vmcnt(18)
    ds_write_b32 v3, v4
    buffer_load_dwordx4 v8, s[20:23], s15 offen offset:2048 nt lds
    s_waitcnt vmcnt(18)
    buffer_load_dwordx4 v9, s[20:23], s15 offen offset:3072 nt lds
    s_addk_i32 m0, -28672
    s_addk_i32 s15, 8192
    s_waitcnt vmcnt(18)
    buffer_load_dwordx4 v6, s[16:19], s15 offen offset:0 nt lds
    s_waitcnt vmcnt(18)
    buffer_load_dwordx4 v7, s[16:19], s15 offen offset:1024 nt lds
    v_mov_b32 v4, 25
    s_waitcnt vmcnt(18)
    ds_write_b32 v3, v4
    buffer_load_dwordx4 v8, s[16:19], s15 offen offset:2048 nt lds
    s_waitcnt vmcnt(18)
    buffer_load_dwordx4 v9, s[16:19], s15 offen offset:3072 nt lds
    s_mov_b32 m0, 131072
    s_addk_i32 s15, -8192
    s_waitcnt vmcnt(18)
    buffer_load_dwordx4 v10, s[24:27], s15 offen offset:0 nt lds
    s_waitcnt vmcnt(18)
    buffer_load_dwordx4 v10, s[24:27], s15 offen offset:1024 nt lds
    v_mov_b32 v4, 26
    s_waitcnt vmcnt(18)
    ds_write_b32 v3, v4
    buffer_load_dwordx4 v10, s[24:27], s15 offen offset:2048 nt lds
    s_waitcnt vmcnt(18)
    buffer_load_dwordx4 v10, s[24:27], s15 offen offset:3072 nt lds
    s_addk_i32 m0, 8192
    s_addk_i32 s15, -4096
    s_waitcnt vmcnt(18)
    buffer_load_dwordx4 v6, s[20:23], s15 offen offset:0 nt lds
    s_waitcnt vmcnt(18)
    buffer_load_dwordx4 v7, s[20:23], s15 offen offset:1024 nt lds
    v_mov_b32 v4, 27
    s_waitcnt vmcnt(18)
    ds_write_b32 v3, v4
    buffer_load_dwordx4 v8, s[20:23], s15 offen offset:2048 nt lds
    s_waitcnt vmcnt(18)
    buffer_load_dwordx4 v9, s[20:23], s15 offen offset:3072 nt lds
    s_addk_i32 m0, -28672
    s_addk_i32 s15, 8192
    s_waitcnt vmcnt(18)
    buffer_load_dwordx4 v6, s[16:19], s15 offen offset:0 nt lds
    s_waitcnt vmcnt(18)
    buffer_load_dwordx4 v7, s[16:19], s15 offen offset:1024 nt lds
    v_mov_b32 v4, 28
    s_waitcnt vmcnt(18)
    ds_write_b32 v3, v4
    buffer_load_dwordx4 v8, s[16:19], s15 offen offset:2048 nt lds
    s_waitcnt vmcnt(18)
    buffer_load_dwordx4 v9, s[16:19], s15 offen offset:3072 nt lds
    s_mov_b32 m0, 143360
    s_addk_i32 s15, -8192
    s_waitcnt vmcnt(18)
    buffer_load_dwordx4 v10, s[24:27], s15 offen offset:0 nt lds
    s_waitcnt vmcnt(18)
    buffer_load_dwordx4 v10, s[24:27], s15 offen offset:1024 nt lds
    v_mov_b32 v4, 29
    s_waitcnt vmcnt(18)
    ds_write_b32 v3, v4
    buffer_load_dwordx4 v10, s[24:27], s15 offen offset:2048 nt lds
    s_waitcnt vmcnt(18)
    buffer_load_dwordx4 v10, s[24:27], s15 offen offset:3072 nt lds
    s_addk_i32 m0, 8192
    s_addk_i32 s15, -4096
    s_waitcnt vmcnt(18)
    buffer_load_dwordx4 v6, s[20:23], s15 offen offset:0 nt lds
    s_waitcnt vmcnt(18)
    buffer_load_dwordx4 v7, s[20:23], s15 offen offset:1024 nt lds
    v_mov_b32 v4, 30
    s_waitcnt vmcnt(18)
    ds_write_b32 v3, v4
    buffer_load_dwordx4 v8, s[20:23], s15 offen offset:2048 nt lds
    s_waitcnt vmcnt(18)
    buffer_load_dwordx4 v9, s[20:23], s15 offen offset:3072 nt lds
    s_addk_i32 m0, -28672
    s_addk_i32 s15, 8192
    s_waitcnt vmcnt(18)
    buffer_load_dwordx4 v6, s[16:19], s15 offen offset:0 nt lds
    s_waitcnt vmcnt(18)
    buffer_load_dwordx4 v7, s[16:19], s15 offen offset:1024 nt lds
    v_mov_b32 v4, 31
    s_waitcnt vmcnt(18)
    ds_write_b32 v3, v4
    buffer_load_dwordx4 v8, s[16:19], s15 offen offset:2048 nt lds
    s_waitcnt vmcnt(18)
    buffer_load_dwordx4 v9, s[16:19], s15 offen offset:3072 nt lds
    s_mov_b32 m0, 155648
    s_addk_i32 s15, -8192
    ds_read_b32 v12, v3 offset:256
    s_waitcnt vmcnt(18)
    buffer_load_dwordx4 v10, s[24:27], s15 offen offset:0 nt lds
    s_waitcnt vmcnt(18)
    buffer_load_dwordx4 v10, s[24:27], s15 offen offset:1024 nt lds
    v_mov_b32 v4, 32
    s_waitcnt vmcnt(18)
    ds_write_b32 v3, v4
    buffer_load_dwordx4 v10, s[24:27], s15 offen offset:2048 nt lds
    s_waitcnt vmcnt(18)
    buffer_load_dwordx4 v10, s[24:27], s15 offen offset:3072 nt lds
    s_mov_b32 m0, 40960
    s_add_u32 s13, s47, 4096
    s_mov_b32 s22, s46
    s_waitcnt lgkmcnt(0)
    v_cmp_eq_u32 vcc, 0, v12
    s_nop 0
    s_cbranch_vccnz L_wait_free
L_free:
    buffer_load_dwordx4 v6, s[20:23], s13 offen offset:0 nt lds
    buffer_load_dwordx4 v7, s[20:23], s13 offen offset:1024 nt lds
    buffer_load_dwordx4 v8, s[20:23], s13 offen offset:2048 nt lds
    buffer_load_dwordx4 v9, s[20:23], s13 offen offset:3072 nt lds
    s_mov_b32 m0, 4096
    s_mov_b32 s22, s18
    s_addk_i32 s15, -4096
    s_waitcnt vmcnt(22)
    buffer_load_dwordx4 v6, s[20:23], s15 offen offset:0 nt lds
    s_waitcnt vmcnt(22)
    buffer_load_dwordx4 v7, s[20:23], s15 offen offset:1024 nt lds
    v_mov_b32 v4, 33
    s_waitcnt vmcnt(22)
    ds_write_b32 v3, v4
    buffer_load_dwordx4 v8, s[20:23], s15 offen offset:2048 nt lds
    s_waitcnt vmcnt(22)
    buffer_load_dwordx4 v9, s[20:23], s15 offen offset:3072 nt lds
    s_mov_b32 m0, 135168
    s_addk_i32 s15, 8192
    s_waitcnt vmcnt(22)
    buffer_load_dwordx4 v6, s[16:19], s15 offen offset:0 nt lds
    s_waitcnt vmcnt(22)
    buffer_load_dwordx4 v7, s[16:19], s15 offen offset:1024 nt lds
    v_mov_b32 v4, 34
    s_waitcnt vmcnt(22)
    ds_write_b32 v3, v4
    buffer_load_dwordx4 v8, s[16:19], s15 offen offset:2048 nt lds
    s_waitcnt vmcnt(22)
    buffer_load_dwordx4 v9, s[16:19], s15 offen offset:3072 nt lds
    s_mov_b32 m0, 45056
    s_add_u32 s13, s47, 4096
    s_mov_b32 s26, s46
    buffer_load_dwordx4 v10, s[24:27], s13 offen offset:0 nt lds
    buffer_load_dwordx4 v10, s[24:27], s13 offen offset:1024 nt lds
    buffer_load_dwordx4 v10, s[24:27], s13 offen offset:2048 nt lds
    buffer_load_dwordx4 v10, s[24:27], s13 offen offset:3072 nt lds
    s_mov_b32 m0, 8192
    s_mov_b32 s26, s18
    s_addk_i32 s15, -8192
    buffer_load_dwordx4 v10, s[24:27], s15 offen offset:0 nt lds
    buffer_load_dwordx4 v10, s[24:27], s15 offen offset:1024 nt lds
    s_waitcnt vmcnt(28)
    buffer_load_dwordx4 v10, s[24:27], s15 offen offset:2048 nt lds
    s_waitcnt vmcnt(28)
    buffer_load_dwordx4 v10, s[24:27], s15 offen offset:3072 nt lds
    s_addk_i32 m0, 8192
    s_addk_i32 s15, -4096
    buffer_load_dwordx4 v6, s[20:23], s15 offen offset:0 nt lds
    buffer_load_dwordx4 v7, s[20:23], s15 offen offset:1024 nt lds
    buffer_load_dwordx4 v8, s[20:23], s15 offen offset:2048 nt lds
    v_mov_b32 v4, 35
    s_waitcnt vmcnt(31)
    ds_write_b32 v3, v4
    buffer_load_dwordx4 v9, s[20:23], s15 offen offset:3072 nt lds
    s_mov_b32 m0, 53248
    s_add_u32 s13, s47, 0
    s_mov_b32 s22, s46
    buffer_load_dwordx4 v6, s[20:23], s13 offen offset:0 nt lds
    buffer_load_dwordx4 v7, s[20:23], s13 offen offset:1024 nt lds
    buffer_load_dwordx4 v8, s[20:23], s13 offen offset:2048 nt lds
    buffer_load_dwordx4 v9, s[20:23], s13 offen offset:3072 nt lds
    s_mov_b32 m0, 147456
    s_addk_i32 s15, 8192
    buffer_load_dwordx4 v6, s[16:19], s15 offen offset:0 nt lds
    buffer_load_dwordx4 v7, s[16:19], s15 offen offset:1024 nt lds
    buffer_load_dwordx4 v8, s[16:19], s15 offen offset:2048 nt lds
    buffer_load_dwordx4 v9, s[16:19], s15 offen offset:3072 nt lds
    s_mov_b32 m0, 20480
    s_addk_i32 s15, -8192
    buffer_load_dwordx4 v10, s[24:27], s15 offen offset:0 nt lds
    buffer_load_dwordx4 v10, s[24:27], s15 offen offset:1024 nt lds
    s_waitcnt vmcnt(41)
    buffer_load_dwordx4 v10, s[24:27], s15 offen offset:2048 nt lds
    s_waitcnt vmcnt(41)
    buffer_load_dwordx4 v10, s[24:27], s15 offen offset:3072 nt lds
    s_mov_b32 m0, 57344
    s_add_u32 s13, s47, 0
    s_mov_b32 s26, s46
    buffer_load_dwordx4 v10, s[24:27], s13 offen offset:0 nt lds
    buffer_load_dwordx4 v10, s[24:27], s13 offen offset:1024 nt lds
    buffer_load_dwordx4 v10, s[24:27], s13 offen offset:2048 nt lds
    buffer_load_dwordx4 v10, s[24:27], s13 offen offset:3072 nt lds
    s_addk_i32 m0, -28672
    s_mov_b32 s22, s18
    s_addk_i32 s15, -4096
    v_mov_b32 v4, 36
    s_waitcnt vmcnt(44)
    ds_write_b32 v3, v4
    buffer_load_dwordx4 v6, s[20:23], s15 offen offset:0 nt lds
    s_waitcnt vmcnt(44)
    buffer_load_dwordx4 v7, s[20:23], s15 offen offset:1024 nt lds
    s_waitcnt vmcnt(44)
    buffer_load_dwordx4 v8, s[20:23], s15 offen offset:2048 nt lds
    s_waitcnt vmcnt(44)
    buffer_load_dwordx4 v9, s[20:23], s15 offen offset:3072 nt lds
    s_addk_i32 m0, -28672
    s_addk_i32 s15, 8192
    v_mov_b32 v4, 37
    s_waitcnt vmcnt(44)
    ds_write_b32 v3, v4
    buffer_load_dwordx4 v6, s[16:19], s15 offen offset:0 nt lds
    s_waitcnt vmcnt(44)
    buffer_load_dwordx4 v7, s[16:19], s15 offen offset:1024 nt lds
    s_waitcnt vmcnt(44)
    buffer_load_dwordx4 v8, s[16:19], s15 offen offset:2048 nt lds
    s_waitcnt vmcnt(44)
    buffer_load_dwordx4 v9, s[16:19], s15 offen offset:3072 nt lds
    s_mov_b32 m0, 32768
    s_mov_b32 s26, s18
    s_addk_i32 s15, -8192
    v_mov_b32 v4, 38
    s_waitcnt vmcnt(44)
    ds_write_b32 v3, v4
    buffer_load_dwordx4 v10, s[24:27], s15 offen offset:0 nt lds
    s_waitcnt vmcnt(44)
    buffer_load_dwordx4 v10, s[24:27], s15 offen offset:1024 nt lds
    s_waitcnt vmcnt(44)
    buffer_load_dwordx4 v10, s[24:27], s15 offen offset:2048 nt lds
    s_waitcnt vmcnt(44)
    buffer_load_dwordx4 v10, s[24:27], s15 offen offset:3072 nt lds
    s_addk_i32 m0, -20480
    s_addk_i32 s15, 4096
    v_mov_b32 v4, 39
    s_waitcnt vmcnt(44)
    ds_write_b32 v3, v4
    buffer_load_dwordx4 v6, s[16:19], s15 offen offset:0 nt lds
    s_waitcnt vmcnt(44)
    buffer_load_dwordx4 v7, s[16:19], s15 offen offset:1024 nt lds
    s_waitcnt vmcnt(44)
    buffer_load_dwordx4 v8, s[16:19], s15 offen offset:2048 nt lds
    s_waitcnt vmcnt(44)
    buffer_load_dwordx4 v9, s[16:19], s15 offen offset:3072 nt lds
    s_addk_i32 m0, 12288
    s_addk_i32 s15, -4096
    v_mov_b32 v4, 40
    s_waitcnt vmcnt(44)
    ds_write_b32 v3, v4
    buffer_load_dwordx4 v6, s[16:19], s15 offen offset:0 nt lds
    s_waitcnt vmcnt(44)
    buffer_load_dwordx4 v7, s[16:19], s15 offen offset:1024 nt lds
    s_waitcnt vmcnt(44)
    buffer_load_dwordx4 v8, s[16:19], s15 offen offset:2048 nt lds
    s_waitcnt vmcnt(44)
    buffer_load_dwordx4 v9, s[16:19], s15 offen offset:3072 nt lds
    v_mov_b32 v4, 41
    s_waitcnt vmcnt(44)
    ds_write_b32 v3, v4
    v_mov_b32 v4, 42
    s_waitcnt vmcnt(40)
    ds_write_b32 v3, v4
    v_mov_b32 v4, 43
    s_waitcnt vmcnt(36)
    ds_write_b32 v3, v4
    v_mov_b32 v4, 44
    s_waitcnt vmcnt(32)
    ds_write_b32 v3, v4
    v_mov_b32 v4, 45
    s_waitcnt vmcnt(28)
    ds_write_b32 v3, v4
    v_mov_b32 v4, 46
    s_waitcnt vmcnt(24)
    ds_write_b32 v3, v4
    v_mov_b32 v4, 47
    s_waitcnt vmcnt(20)
    ds_write_b32 v3, v4
    v_mov_b32 v4, 48
    s_waitcnt vmcnt(16)
    ds_write_b32 v3, v4
    v_mov_b32 v4, 49
    s_waitcnt vmcnt(12)
    ds_write_b32 v3, v4
    v_mov_b32 v4, 50
    s_waitcnt vmcnt(8)
    ds_write_b32 v3, v4
    v_mov_b32 v4, 51
    s_waitcnt vmcnt(4)
    ds_write_b32 v3, v4
    v_mov_b32 v4, 52
    s_waitcnt vmcnt(0)
    ds_write_b32 v3, v4
    s_endpgm
L_wait_free:
    ds_read_b32 v12, v3 offset:256
    s_waitcnt lgkmcnt(0)
    v_cmp_eq_u32 vcc, 0, v12
    s_nop 0
    s_cbranch_vccnz L_wait_free
    s_branch L_free
L_cons:
    s_cmp_eq_u32 s3, 320
    s_cbranch_scc1 L_storer
    v_and_b32 v7, 15, v1
    v_xor_b32 v8, v7, v5
    v_lshlrev_b32 v8, 4, v8
    v_lshl_add_u32 v12, v7, 8, v8
    v_xor_b32 v13, 64, v12
    v_xor_b32 v14, 0x80, v12
    v_xor_b32 v15, 64, v14
    v_lshlrev_b32 v8, 4, v7
    v_lshl_add_u32 v16, v5, 10, v8
    s_mov_b32 s32, 0x3e0293ee
    s_mov_b32 s33, s32
    s_mov_b32 s34, 0x05040100
    s_mov_b32 s35, 0x07060302
    v_lshlrev_b32 v5, 2, v5
    v_add_u32 v8, 0, v5
    v_cmp_gt_u32 s[36:37], v8, v7
    v_add_u32 v8, 1, v5
    v_cmp_gt_u32 s[38:39], v8, v7
    v_add_u32 v8, 2, v5
    v_cmp_gt_u32 s[40:41], v8, v7
    v_add_u32 v8, 3, v5
    v_cmp_gt_u32 s[42:43], v8, v7
    v_mov_b32 v8, 0xffff
    v_mov_b32 v9, 0xffff0000
    v_cndmask_b32 v18, 0, v8, s[36:37]
    v_cndmask_b32 v10, 0, v9, s[38:39]
    v_or_b32 v18, v18, v10
    v_cndmask_b32 v19, 0, v8, s[40:41]
    v_cndmask_b32 v10, 0, v9, s[42:43]
    v_or_b32 v19, v19, v10
    s_mov_b32 s60, 0x100d0a07
    s_mov_b32 s61, 0x1c191613
    s_mov_b32 s62, 0x2a25221f
    s_mov_b32 s63, 0x3433322e
    s_and_b32 s57, s2, 7
    s_lshl_b32 s57, s57, 4
    s_add_u32 s57, s57, 15
    s_add_u32 s12, s12, 61440
    s_lshr_b32 s14, s3, 6
    s_sub_u32 s14, s14, 1
L_tile:
    s_add_u32 s48, s14, 2
    s_cmp_ge_u32 s48, 13
    s_cselect_b32 s56, 13, 0
    s_sub_u32 s48, s48, s56
    s_mul_i32 s48, s48, 12288
    v_add_u32 v20, s48, v12
    v_add_u32 v21, s48, v13
    v_add_u32 v22, s48, v14
    v_add_u32 v23, s48, v15
    v_add_u32 v32, s48, v16
    s_add_u32 s49, s14, 1
    s_cmp_ge_u32 s49, 13
    s_cselect_b32 s56, 13, 0
    s_sub_u32 s49, s49, s56
    s_mul_i32 s49, s49, 12288
    v_add_u32 v24, s49, v12
    v_add_u32 v25, s49, v13
    v_add_u32 v26, s49, v14
    v_add_u32 v27, s49, v15
    v_add_u32 v33, s49, v16
    s_add_u32 s50, s14, 0
    s_cmp_ge_u32 s50, 13
    s_cselect_b32 s56, 13, 0
    s_sub_u32 s50, s50, s56
    s_mul_i32 s50, s50, 12288
    v_add_u32 v28, s50, v12
    v_add_u32 v29, s50, v13
    v_add_u32 v30, s50, v14
    v_add_u32 v31, s50, v15
    v_add_u32 v34, s50, v16
    s_cmp_ge_u32 s14, 8
    s_cselect_b64 s[58:59], s[62:63], s[60:61]
    s_lshl_b32 s56, s14, 3
    s_lshr_b64 s[58:59], s[58:59], s56
    s_and_b32 s53, s58, 0xff
    s_sub_u32 s56, s57, s14
    s_cmp_lt_u32 s56, 2
    s_cselect_b32 s51, 0xff800000, 0
    s_cmp_lt_u32 s56, 1
    s_cselect_b32 s52, 0xff800000, 0
    v_mov_b32 v40, s51
    v_mov_b32 v44, s52
    v_mov_b32 v41, s51
    v_mov_b32 v45, s52
    v_mov_b32 v42, s51
    v_mov_b32 v46, s52
    v_mov_b32 v43, s51
    v_mov_b32 v47, s52
    s_lshl_b32 s15, s14, 12
    s_sub_u32 s15, s12, s15
    s_lshl_b32 s56, 1, s14
    v_mov_b32 v10, s56
L_poll:
    ds_read_b32 v38, v3
    s_waitcnt lgkmcnt(0)
    v_cmp_gt_u32 vcc, s53, v38
    s_nop 0
    s_cbranch_vccnz L_poll
    ds_read_b128 v[60:63], v28
    ds_read_b128 v[76:79], v20 offset:4096
    ds_read_b128 v[92:95], v24 offset:4096
    ds_read_b128 v[108:111], v28 offset:4096
    ds_read_b128 v[64:67], v29
    ds_read_b128 v[80:83], v21 offset:4096
    ds_read_b128 v[96:99], v25 offset:4096
    ds_read_b128 v[112:115], v29 offset:4096
    ds_read_b128 v[68:71], v30
    ds_read_b128 v[84:87], v22 offset:4096
    ds_read_b128 v[100:103], v26 offset:4096
    ds_read_b128 v[116:119], v30 offset:4096
    s_waitcnt lgkmcnt(8)
    v_mfma_f32_16x16x32_bf16 v[40:43], v[76:79], v[60:63], v[40:43]
    ds_read_b128 v[72:75], v31
    ds_read_b128 v[88:91], v23 offset:4096
    v_mfma_f32_16x16x32_bf16 v[44:47], v[92:95], v[60:63], v[44:47]
    ds_read_b128 v[104:107], v27 offset:4096
    ds_read_b128 v[120:123], v31 offset:4096
    v_mfma_f32_16x16x32_bf16 v[48:51], v[108:111], v[60:63], 0
    s_waitcnt lgkmcnt(8)
    v_mfma_f32_16x16x32_bf16 v[40:43], v[80:83], v[64:67], v[40:43]
    ds_read_b128 v[156:159], v34 offset:8192
    ds_read_b128 v[160:163], v34 offset:8448
    v_mfma_f32_16x16x32_bf16 v[44:47], v[96:99], v[64:67], v[44:47]
    ds_read_b128 v[164:167], v34 offset:8704
    ds_read_b128 v[168:171], v34 offset:8960
    v_mfma_f32_16x16x32_bf16 v[48:51], v[112:115], v[64:67], v[48:51]
    s_waitcnt lgkmcnt(8)
    v_mfma_f32_16x16x32_bf16 v[40:43], v[84:87], v[68:71], v[40:43]
    ds_read_b128 v[124:127], v32 offset:8192
    ds_read_b128 v[128:131], v32 offset:8448
    v_mfma_f32_16x16x32_bf16 v[44:47], v[100:103], v[68:71], v[44:47]
    ds_read_b128 v[132:135], v32 offset:8704
    ds_read_b128 v[136:139], v32 offset:8960
    v_mfma_f32_16x16x32_bf16 v[48:51], v[116:119], v[68:71], v[48:51]
    s_waitcnt lgkmcnt(8)
    v_mfma_f32_16x16x32_bf16 v[40:43], v[88:91], v[72:75], v[40:43]
    ds_read_b128 v[140:143], v33 offset:8192
    ds_read_b128 v[144:147], v33 offset:8448
    v_mfma_f32_16x16x32_bf16 v[44:47], v[104:107], v[72:75], v[44:47]
    ds_read_b128 v[148:151], v33 offset:8704
    ds_read_b128 v[152:155], v33 offset:8960
    v_mfma_f32_16x16x32_bf16 v[48:51], v[120:123], v[72:75], v[48:51]
    s_waitcnt lgkmcnt(8)
    v_perm_b32 v176, v160, v156, s34
    v_perm_b32 v182, v160, v156, s35
    v_perm_b32 v177, v168, v164, s34
    v_perm_b32 v183, v168, v164, s35
    v_perm_b32 v188, v161, v157, s34
    v_perm_b32 v194, v161, v157, s35
    v_max3_f32 v36, v44, v45, v46
    v_cndmask_b32 v40, v48, v40, s[36:37]
    v_cndmask_b32 v41, v49, v41, s[38:39]
    v_cndmask_b32 v42, v50, v42, s[40:41]
    v_cndmask_b32 v43, v51, v43, s[42:43]
    v_max3_f32 v36, v36, v47, v40
    v_max3_f32 v48, v41, v42, v43
    v_max_f32 v37, v36, v48
    v_max_f32 v36, v36, v48
    v_perm_b32 v189, v169, v165, s34
    v_perm_b32 v195, v169, v165, s35
    v_permlane16_swap_b32 v36, v37
    v_max_f32 v48, v36, v37
    v_max_f32 v37, v36, v37
    v_perm_b32 v200, v162, v158, s34
    v_perm_b32 v206, v162, v158, s35
    v_permlane32_swap_b32 v48, v37
    v_max_f32 v36, v48, v37
    v_pk_add_f32 v[40:41], v[40:41], v[36:37] op_sel_hi:[1,0] neg_lo:[0,1] neg_hi:[0,1]
    v_pk_add_f32 v[42:43], v[42:43], v[36:37] op_sel_hi:[1,0] neg_lo:[0,1] neg_hi:[0,1]
    v_pk_add_f32 v[44:45], v[44:45], v[36:37] op_sel_hi:[1,0] neg_lo:[0,1] neg_hi:[0,1]
    v_pk_add_f32 v[46:47], v[46:47], v[36:37] op_sel_hi:[1,0] neg_lo:[0,1] neg_hi:[0,1]
    v_pk_mul_f32 v[40:41], v[40:41], s[32:33]
    v_pk_mul_f32 v[42:43], v[42:43], s[32:33]
    v_pk_mul_f32 v[44:45], v[44:45], s[32:33]
    v_pk_mul_f32 v[46:47], v[46:47], s[32:33]
    v_exp_f32 v40, v40
    v_exp_f32 v41, v41
    v_exp_f32 v42, v42
    v_exp_f32 v43, v43
    v_exp_f32 v44, v44
    v_exp_f32 v45, v45
    v_exp_f32 v46, v46
    v_exp_f32 v47, v47
    v_pk_add_f32 v[48:49], v[40:41], v[42:43]
    v_pk_add_f32 v[50:51], v[44:45], v[46:47]
    v_pk_add_f32 v[48:49], v[48:49], v[50:51]
    v_pk_add_f32 v[36:37], v[48:49], v[48:49] op_sel:[0,1] op_sel_hi:[1,0]
    v_perm_b32 v201, v170, v166, s34
    v_perm_b32 v207, v170, v166, s35
    v_permlane16_swap_b32 v36, v37
    v_pk_add_f32 v[36:37], v[36:37], v[36:37] op_sel:[0,1] op_sel_hi:[1,0]
    v_perm_b32 v212, v163, v159, s34
    v_perm_b32 v218, v163, v159, s35
    v_permlane32_swap_b32 v36, v37
    v_add_f32 v36, v36, v37
    v_rcp_f32 v36, v36
    s_waitcnt lgkmcnt(0)
    v_pk_mul_f32 v[40:41], v[40:41], v[36:37] op_sel_hi:[1,0]
    v_pk_mul_f32 v[42:43], v[42:43], v[36:37] op_sel_hi:[1,0]
    v_cvt_pk_bf16_f32 v52, v40, v41
    v_cvt_pk_bf16_f32 v53, v42, v43
    v_bfi_b32 v56, v18, 0, v52
    v_bfi_b32 v57, v19, 0, v53
    v_perm_b32 v213, v171, v167, s34
    v_perm_b32 v219, v171, v167, s35
    v_mfma_f32_16x16x16_bf16 v[60:63], v[56:57], v[176:177], 0
    v_pk_mul_f32 v[44:45], v[44:45], v[36:37] op_sel_hi:[1,0]
    v_pk_mul_f32 v[46:47], v[46:47], v[36:37] op_sel_hi:[1,0]
    v_cvt_pk_bf16_f32 v54, v44, v45
    v_mfma_f32_16x16x16_bf16 v[64:67], v[56:57], v[182:183], 0
    v_cvt_pk_bf16_f32 v55, v46, v47
    v_and_b32 v52, v52, v18
    v_and_b32 v53, v53, v19
    v_mfma_f32_16x16x16_bf16 v[68:71], v[56:57], v[188:189], 0
    v_perm_b32 v172, v128, v124, s34
    v_perm_b32 v178, v128, v124, s35
    v_perm_b32 v173, v136, v132, s34
    v_mfma_f32_16x16x16_bf16 v[72:75], v[56:57], v[194:195], 0
    v_perm_b32 v179, v136, v132, s35
    v_perm_b32 v174, v144, v140, s34
    v_perm_b32 v180, v144, v140, s35
    v_mfma_f32_16x16x16_bf16 v[76:79], v[56:57], v[200:201], 0
    v_perm_b32 v175, v152, v148, s34
    v_perm_b32 v181, v152, v148, s35
    v_perm_b32 v184, v129, v125, s34
    v_mfma_f32_16x16x16_bf16 v[80:83], v[56:57], v[206:207], 0
    v_perm_b32 v190, v129, v125, s35
    v_perm_b32 v185, v137, v133, s34
    v_perm_b32 v191, v137, v133, s35
    v_mfma_f32_16x16x16_bf16 v[84:87], v[56:57], v[212:213], 0
    v_perm_b32 v186, v145, v141, s34
    v_perm_b32 v192, v145, v141, s35
    v_perm_b32 v187, v153, v149, s34
    v_mfma_f32_16x16x16_bf16 v[88:91], v[56:57], v[218:219], 0
    v_perm_b32 v193, v153, v149, s35
    v_mfma_f32_16x16x32_bf16 v[60:63], v[52:55], v[172:175], v[60:63]
    v_perm_b32 v196, v130, v126, s34
    v_perm_b32 v202, v130, v126, s35
    v_perm_b32 v197, v138, v134, s34
    v_perm_b32 v203, v138, v134, s35
    v_mfma_f32_16x16x32_bf16 v[64:67], v[52:55], v[178:181], v[64:67]
    v_perm_b32 v198, v146, v142, s34
    v_perm_b32 v204, v146, v142, s35
    v_perm_b32 v199, v154, v150, s34
    v_perm_b32 v205, v154, v150, s35
    v_mfma_f32_16x16x32_bf16 v[68:71], v[52:55], v[184:187], v[68:71]
    v_perm_b32 v208, v131, v127, s34
    v_perm_b32 v214, v131, v127, s35
    v_perm_b32 v209, v139, v135, s34
    v_mfma_f32_16x16x32_bf16 v[72:75], v[52:55], v[190:193], v[72:75]
    v_perm_b32 v215, v139, v135, s35
    v_perm_b32 v210, v147, v143, s34
    v_perm_b32 v216, v147, v143, s35
    v_mfma_f32_16x16x32_bf16 v[76:79], v[52:55], v[196:199], v[76:79]
    v_perm_b32 v211, v155, v151, s34
    v_perm_b32 v217, v155, v151, s35
    v_cvt_pk_bf16_f32 v108, v60, v64
    v_mfma_f32_16x16x32_bf16 v[80:83], v[52:55], v[202:205], v[80:83]
    v_cvt_pk_bf16_f32 v112, v61, v65
    v_cvt_pk_bf16_f32 v116, v62, v66
    v_cvt_pk_bf16_f32 v120, v63, v67
    v_mfma_f32_16x16x32_bf16 v[84:87], v[52:55], v[208:211], v[84:87]
    v_cvt_pk_bf16_f32 v109, v68, v72
    v_cvt_pk_bf16_f32 v113, v69, v73
    v_mfma_f32_16x16x32_bf16 v[88:91], v[52:55], v[214:217], v[88:91]
    v_cvt_pk_bf16_f32 v117, v70, v74
    v_cvt_pk_bf16_f32 v121, v71, v75
    v_cvt_pk_bf16_f32 v110, v76, v80
    v_cvt_pk_bf16_f32 v114, v77, v81
    v_cvt_pk_bf16_f32 v118, v78, v82
    v_cvt_pk_bf16_f32 v122, v79, v83
    s_cmp_lt_u32 s14, 13
    s_cbranch_scc1 L_park
    v_cvt_pk_bf16_f32 v111, v84, v88
    buffer_store_dwordx4 v[108:111], v16, s[28:31], s15 offen offset:0 nt
    v_cvt_pk_bf16_f32 v115, v85, v89
    buffer_store_dwordx4 v[112:115], v16, s[28:31], s15 offen offset:256 nt
    v_cvt_pk_bf16_f32 v119, v86, v90
    buffer_store_dwordx4 v[116:119], v16, s[28:31], s15 offen offset:512 nt
    v_cvt_pk_bf16_f32 v123, v87, v91
    buffer_store_dwordx4 v[120:123], v16, s[28:31], s15 offen offset:768 nt
L_next:
    s_add_u32 s14, s14, 4
    s_cmp_lt_u32 s14, 16
    s_cbranch_scc1 L_tile
    s_endpgm
L_park:
    v_cvt_pk_bf16_f32 v111, v84, v88
    ds_write_b128 v34, v[108:111] offset:0
    v_cvt_pk_bf16_f32 v115, v85, v89
    ds_write_b128 v34, v[112:115] offset:256
    v_cvt_pk_bf16_f32 v119, v86, v90
    ds_write_b128 v34, v[116:119] offset:512
    v_cvt_pk_bf16_f32 v123, v87, v91
    ds_write_b128 v34, v[120:123] offset:768
    ds_or_b32 v3, v10 offset:512
    s_branch L_next
L_storer:
    s_add_u32 s15, s12, 65536
    v_mov_b32 v12, 1
    v_add_u32 v14, 61440, v10
    v_add_u32 v15, 122880, v10
L_ready0:
    ds_read_b32 v13, v3 offset:512
    s_waitcnt lgkmcnt(0)
    v_readfirstlane_b32 s48, v13
    s_nop 0
    s_bitcmp1_b32 s48, 0
    s_cbranch_scc0 L_ready0
    ds_read_b128 v[16:19], v10 offset:0
    ds_read_b128 v[20:23], v10 offset:1024
    ds_read_b128 v[24:27], v10 offset:2048
    ds_read_b128 v[28:31], v10 offset:3072
L_ready1:
    ds_read_b32 v13, v3 offset:512
    s_waitcnt lgkmcnt(0)
    v_readfirstlane_b32 s48, v13
    s_nop 0
    s_bitcmp1_b32 s48, 1
    s_cbranch_scc0 L_ready1
    ds_read_b128 v[32:35], v10 offset:12288
    ds_read_b128 v[36:39], v10 offset:13312
    ds_read_b128 v[40:43], v10 offset:14336
    ds_read_b128 v[44:47], v10 offset:15360
L_ready2:
    ds_read_b32 v13, v3 offset:512
    s_waitcnt lgkmcnt(0)
    v_readfirstlane_b32 s48, v13
    s_nop 0
    s_bitcmp1_b32 s48, 2
    s_cbranch_scc0 L_ready2
    ds_read_b128 v[48:51], v10 offset:24576
    ds_read_b128 v[52:55], v10 offset:25600
    ds_read_b128 v[56:59], v10 offset:26624
    ds_read_b128 v[60:63], v10 offset:27648
L_ready3:
    ds_read_b32 v13, v3 offset:512
    s_waitcnt lgkmcnt(0)
    v_readfirstlane_b32 s48, v13
    s_nop 0
    s_bitcmp1_b32 s48, 3
    s_cbranch_scc0 L_ready3
    ds_read_b128 v[64:67], v10 offset:36864
    ds_read_b128 v[68:71], v10 offset:37888
    ds_read_b128 v[72:75], v10 offset:38912
    ds_read_b128 v[76:79], v10 offset:39936
L_ready4:
    ds_read_b32 v13, v3 offset:512
    s_waitcnt lgkmcnt(0)
    v_readfirstlane_b32 s48, v13
    s_nop 0
    s_bitcmp1_b32 s48, 4
    s_cbranch_scc0 L_ready4
    ds_read_b128 v[80:83], v10 offset:49152
    ds_read_b128 v[84:87], v10 offset:50176
    ds_read_b128 v[88:91], v10 offset:51200
    ds_read_b128 v[92:95], v10 offset:52224
    s_waitcnt lgkmcnt(0)
    ds_write_b32 v3, v12 offset:256
L_ready5:
    ds_read_b32 v13, v3 offset:512
    s_waitcnt lgkmcnt(0)
    v_readfirstlane_b32 s48, v13
    s_nop 0
    s_bitcmp1_b32 s48, 5
    s_cbranch_scc0 L_ready5
    ds_read_b128 v[96:99], v14 offset:0
    ds_read_b128 v[100:103], v14 offset:1024
    ds_read_b128 v[104:107], v14 offset:2048
    ds_read_b128 v[108:111], v14 offset:3072
L_ready6:
    ds_read_b32 v13, v3 offset:512
    s_waitcnt lgkmcnt(0)
    v_readfirstlane_b32 s48, v13
    s_nop 0
    s_bitcmp1_b32 s48, 6
    s_cbranch_scc0 L_ready6
    ds_read_b128 v[112:115], v14 offset:12288
    ds_read_b128 v[116:119], v14 offset:13312
    ds_read_b128 v[120:123], v14 offset:14336
    ds_read_b128 v[124:127], v14 offset:15360
L_ready7:
    ds_read_b32 v13, v3 offset:512
    s_waitcnt lgkmcnt(0)
    v_readfirstlane_b32 s48, v13
    s_nop 0
    s_bitcmp1_b32 s48, 7
    s_cbranch_scc0 L_ready7
    ds_read_b128 v[128:131], v14 offset:24576
    ds_read_b128 v[132:135], v14 offset:25600
    ds_read_b128 v[136:139], v14 offset:26624
    ds_read_b128 v[140:143], v14 offset:27648
L_ready8:
    ds_read_b32 v13, v3 offset:512
    s_waitcnt lgkmcnt(0)
    v_readfirstlane_b32 s48, v13
    s_nop 0
    s_bitcmp1_b32 s48, 8
    s_cbranch_scc0 L_ready8
    ds_read_b128 v[144:147], v14 offset:36864
    ds_read_b128 v[148:151], v14 offset:37888
    ds_read_b128 v[152:155], v14 offset:38912
    ds_read_b128 v[156:159], v14 offset:39936
L_ready9:
    ds_read_b32 v13, v3 offset:512
    s_waitcnt lgkmcnt(0)
    v_readfirstlane_b32 s48, v13
    s_nop 0
    s_bitcmp1_b32 s48, 9
    s_cbranch_scc0 L_ready9
    ds_read_b128 v[160:163], v14 offset:49152
    ds_read_b128 v[164:167], v14 offset:50176
    ds_read_b128 v[168:171], v14 offset:51200
    ds_read_b128 v[172:175], v14 offset:52224
L_ready10:
    ds_read_b32 v13, v3 offset:512
    s_waitcnt lgkmcnt(0)
    v_readfirstlane_b32 s48, v13
    s_nop 0
    s_bitcmp1_b32 s48, 10
    s_cbranch_scc0 L_ready10
    ds_read_b128 v[176:179], v15 offset:0
    ds_read_b128 v[180:183], v15 offset:1024
    ds_read_b128 v[184:187], v15 offset:2048
    ds_read_b128 v[188:191], v15 offset:3072
    s_mov_b32 s49, 0
L_prog_new0:
    s_mov_b32 s50, 8
L_prog_same0:
    ds_read_b32 v13, v3
    s_mov_b32 s51, s49
    s_waitcnt lgkmcnt(0)
    v_readfirstlane_b32 s49, v13
    s_nop 0
    s_cmp_ge_u32 s49, 52
    s_cbranch_scc1 L_go0
    s_cmp_lg_u32 s49, s51
    s_cbranch_scc1 L_prog_new0
    s_sub_u32 s50, s50, 1
    s_cbranch_scc0 L_prog_same0
L_go0:
    s_addk_i32 s15, -4096
    buffer_store_dwordx4 v[16:19], v10, s[28:31], s15 offen offset:0 nt
    buffer_store_dwordx4 v[20:23], v10, s[28:31], s15 offen offset:1024 nt
    buffer_store_dwordx4 v[24:27], v10, s[28:31], s15 offen offset:2048 nt
    buffer_store_dwordx4 v[28:31], v10, s[28:31], s15 offen offset:3072 nt
    s_addk_i32 s15, -4096
    buffer_store_dwordx4 v[32:35], v10, s[28:31], s15 offen offset:0 nt
    buffer_store_dwordx4 v[36:39], v10, s[28:31], s15 offen offset:1024 nt
    buffer_store_dwordx4 v[40:43], v10, s[28:31], s15 offen offset:2048 nt
    buffer_store_dwordx4 v[44:47], v10, s[28:31], s15 offen offset:3072 nt
    s_addk_i32 s15, -4096
    buffer_store_dwordx4 v[48:51], v10, s[28:31], s15 offen offset:0 nt
    buffer_store_dwordx4 v[52:55], v10, s[28:31], s15 offen offset:1024 nt
    buffer_store_dwordx4 v[56:59], v10, s[28:31], s15 offen offset:2048 nt
    buffer_store_dwordx4 v[60:63], v10, s[28:31], s15 offen offset:3072 nt
    s_addk_i32 s15, -4096
    buffer_store_dwordx4 v[64:67], v10, s[28:31], s15 offen offset:0 nt
    buffer_store_dwordx4 v[68:71], v10, s[28:31], s15 offen offset:1024 nt
    buffer_store_dwordx4 v[72:75], v10, s[28:31], s15 offen offset:2048 nt
    buffer_store_dwordx4 v[76:79], v10, s[28:31], s15 offen offset:3072 nt
    s_addk_i32 s15, -4096
    buffer_store_dwordx4 v[80:83], v10, s[28:31], s15 offen offset:0 nt
    buffer_store_dwordx4 v[84:87], v10, s[28:31], s15 offen offset:1024 nt
    buffer_store_dwordx4 v[88:91], v10, s[28:31], s15 offen offset:2048 nt
    buffer_store_dwordx4 v[92:95], v10, s[28:31], s15 offen offset:3072 nt
    s_addk_i32 s15, -4096
    buffer_store_dwordx4 v[96:99], v10, s[28:31], s15 offen offset:0 nt
    buffer_store_dwordx4 v[100:103], v10, s[28:31], s15 offen offset:1024 nt
    buffer_store_dwordx4 v[104:107], v10, s[28:31], s15 offen offset:2048 nt
    buffer_store_dwordx4 v[108:111], v10, s[28:31], s15 offen offset:3072 nt
    s_addk_i32 s15, -4096
    buffer_store_dwordx4 v[112:115], v10, s[28:31], s15 offen offset:0 nt
    buffer_store_dwordx4 v[116:119], v10, s[28:31], s15 offen offset:1024 nt
    buffer_store_dwordx4 v[120:123], v10, s[28:31], s15 offen offset:2048 nt
    buffer_store_dwordx4 v[124:127], v10, s[28:31], s15 offen offset:3072 nt
    s_addk_i32 s15, -4096
    buffer_store_dwordx4 v[128:131], v10, s[28:31], s15 offen offset:0 nt
    buffer_store_dwordx4 v[132:135], v10, s[28:31], s15 offen offset:1024 nt
    buffer_store_dwordx4 v[136:139], v10, s[28:31], s15 offen offset:2048 nt
    buffer_store_dwordx4 v[140:143], v10, s[28:31], s15 offen offset:3072 nt
    s_addk_i32 s15, -4096
    buffer_store_dwordx4 v[144:147], v10, s[28:31], s15 offen offset:0 nt
    buffer_store_dwordx4 v[148:151], v10, s[28:31], s15 offen offset:1024 nt
    buffer_store_dwordx4 v[152:155], v10, s[28:31], s15 offen offset:2048 nt
    buffer_store_dwordx4 v[156:159], v10, s[28:31], s15 offen offset:3072 nt
    s_addk_i32 s15, -4096
    buffer_store_dwordx4 v[160:163], v10, s[28:31], s15 offen offset:0 nt
    buffer_store_dwordx4 v[164:167], v10, s[28:31], s15 offen offset:1024 nt
    buffer_store_dwordx4 v[168:171], v10, s[28:31], s15 offen offset:2048 nt
    buffer_store_dwordx4 v[172:175], v10, s[28:31], s15 offen offset:3072 nt
    s_addk_i32 s15, -4096
    buffer_store_dwordx4 v[176:179], v10, s[28:31], s15 offen offset:0 nt
    buffer_store_dwordx4 v[180:183], v10, s[28:31], s15 offen offset:1024 nt
    buffer_store_dwordx4 v[184:187], v10, s[28:31], s15 offen offset:2048 nt
    buffer_store_dwordx4 v[188:191], v10, s[28:31], s15 offen offset:3072 nt
L_ready11:
    ds_read_b32 v13, v3 offset:512
    s_waitcnt lgkmcnt(0)
    v_readfirstlane_b32 s48, v13
    s_nop 0
    s_bitcmp1_b32 s48, 11
    s_cbranch_scc0 L_ready11
    ds_read_b128 v[192:195], v15 offset:12288
    ds_read_b128 v[196:199], v15 offset:13312
    ds_read_b128 v[200:203], v15 offset:14336
    ds_read_b128 v[204:207], v15 offset:15360
    s_waitcnt lgkmcnt(0)
    s_addk_i32 s15, -4096
    buffer_store_dwordx4 v[192:195], v10, s[28:31], s15 offen offset:0 nt
    buffer_store_dwordx4 v[196:199], v10, s[28:31], s15 offen offset:1024 nt
    buffer_store_dwordx4 v[200:203], v10, s[28:31], s15 offen offset:2048 nt
    buffer_store_dwordx4 v[204:207], v10, s[28:31], s15 offen offset:3072 nt
L_ready12:
    ds_read_b32 v13, v3 offset:512
    s_waitcnt lgkmcnt(0)
    v_readfirstlane_b32 s48, v13
    s_nop 0
    s_bitcmp1_b32 s48, 12
    s_cbranch_scc0 L_ready12
    ds_read_b128 v[208:211], v15 offset:24576
    ds_read_b128 v[212:215], v15 offset:25600
    ds_read_b128 v[216:219], v15 offset:26624
    ds_read_b128 v[220:223], v15 offset:27648
    s_waitcnt lgkmcnt(0)
    s_addk_i32 s15, -4096
    buffer_store_dwordx4 v[208:211], v10, s[28:31], s15 offen offset:0 nt
    buffer_store_dwordx4 v[212:215], v10, s[28:31], s15 offen offset:1024 nt
    buffer_store_dwordx4 v[216:219], v10, s[28:31], s15 offen offset:2048 nt
    buffer_store_dwordx4 v[220:223], v10, s[28:31], s15 offen offset:3072 nt
L_end:
    s_endpgm
.fill 640, 4, 0xbf810000
.section .rodata,"a"
.p2align 6
.amdhsa_kernel standalone__sliding_local_fixed_window__prompt_kernel
  .amdhsa_next_free_vgpr 224
  .amdhsa_next_free_sgpr 72
  .amdhsa_accum_offset 224
  .amdhsa_group_segment_fixed_size 0
  .amdhsa_kernarg_size 48
  .amdhsa_user_sgpr_count 2
  .amdhsa_user_sgpr_kernarg_segment_ptr 1
  .amdhsa_system_sgpr_workgroup_id_x 1
  .amdhsa_float_denorm_mode_32 3
.end_amdhsa_kernel
```
